```python
import torch

def _softmax(x, axis=-1):
    return torch.softmax(x, dim=axis)
def _gelu(x):
    return torch.nn.functional.gelu(x, approximate="tanh")
def _silu(x):
    return torch.nn.functional.silu(x)
def _sigmoid(x):
    return torch.sigmoid(x)
def _layernorm(x, axis=-1, eps=1e-5):
    m = x.mean(dim=axis, keepdim=True)
    v = x.var(dim=axis, keepdim=True, unbiased=False)
    return (x - m) / torch.sqrt(v + eps)
def _scatter_add(tgt, idx, src, axis=0):
    return tgt.clone().index_add_(axis, idx, src)
def _segment_sum(src, seg, n):
    out = torch.zeros((n,) + src.shape[1:], dtype=src.dtype)
    return out.index_add_(0, seg, src)
def _pad(x, pw):
    flat = tuple(v for pair in reversed(pw) for v in pair)
    return torch.nn.functional.pad(x, flat)

kernel_name = 'standalone__paged_block_table_kv_pagedattention__decode'

def setup_inputs():

    _w = (lambda a: (lambda t: t.to(torch.bfloat16) if t.is_floating_point() else t)(torch.as_tensor(a)))
    B, Hq, Hkv, Sq, Skv, D = 2, 32, 4, 1, 32768, 128
    bs = 16
    nbps = max(1, Skv // bs)
    num_phys = B * nbps + 4
    bt = torch.randperm(num_phys)[: B * nbps].reshape(B, nbps).to(torch.int64)
    cl = (nbps * bs - (torch.arange(1, B + 1, dtype=torch.int64) * 2654435761) % max(1, nbps * bs // 2)).to(torch.int64)
    return {
        "q": _w((lambda *s: torch.randn(*s, dtype=torch.bfloat16) * 0.8)(B, Hq, Sq, D)),
        "k_cache": _w((lambda *s: torch.randn(*s, dtype=torch.bfloat16) * 0.8)(num_phys, bs, Hkv, D)),
        "v_cache": _w((lambda *s: torch.randn(*s, dtype=torch.bfloat16) * 0.05)(num_phys, bs, Hkv, D)),
        "block_table": _w(bt),
        "context_lens": _w(cl),
    }

def reference(q, k_cache, v_cache, block_table, context_lens):
    B, Hq, Sq, D = q.shape
    bs = k_cache.shape[1]
    Hkv = k_cache.shape[2]
    nbps = block_table.shape[1]
    Skv = nbps * bs
    bt = block_table.reshape(-1)
    k = (lambda x, *d: x.permute(*d))(k_cache[bt].reshape(B, Skv, Hkv, D), 0, 2, 1, 3)
    v = (lambda x, *d: x.permute(*d))(v_cache[bt].reshape(B, Skv, Hkv, D), 0, 2, 1, 3)
    g = Hq // Hkv
    qg = q.reshape(B, Hkv, g, Sq, D)
    scores = torch.einsum("bhgqd,bhkd->bhgqk", qg, k) * (D ** -0.5)
    pos = torch.arange(Skv)
    msk = pos[None, :] < context_lens[:, None]
    scores = torch.where(msk[:, None, None, None, :], scores, -1e9)
    p = _softmax(scores, axis=-1)
    out = torch.einsum("bhgqk,bhkd->bhgqd", p, v)
    return out.reshape(B, Hq, Sq, D)
```

```asm
; @launch grid=(256,1,1) block=(512,1,1) lds=26624
.amdgcn_target "amdgcn-amd-amdhsa--gfx950"
.text
.globl standalone__paged_block_table_kv_pagedattention__decode_kernel
.p2align 8
.type standalone__paged_block_table_kv_pagedattention__decode_kernel,@function
standalone__paged_block_table_kv_pagedattention__decode_kernel:
  s_load_dwordx16 s[8:23], s[0:1], 0
  s_cmp_ge_u32 s2, 256
  s_cbranch_scc1 L_end
  s_getpc_b64 s[62:63]
L_pc:
  v_lshlrev_b32 v1, 4, v0
  s_sub_u32 s62, s62, L_pc-standalone__paged_block_table_kv_pagedattention__decode_kernel
  s_subb_u32 s63, s63, 0
  global_load_dwordx4 v[24:27], v1, s[62:63]
  v_lshrrev_b32 v1, 6, v0
  v_and_b32 v2, 63, v0
  v_readfirstlane_b32 s3, v1
  v_and_b32 v3, 15, v0
  v_lshrrev_b32 v4, 4, v2
  s_and_b32 s4, s2, 1
  s_lshr_b32 s5, s2, 1
  s_xor_b32 s5, s5, s3
  s_and_b32 s5, s5, 1
  s_lshr_b32 s6, s2, 2
  s_lshr_b32 s7, s3, 1
  s_lshl_b32 s7, s7, 6
  s_mul_i32 s62, s5, 63
  s_xor_b32 s62, s62, s6
  s_add_u32 s7, s7, s62
  s_lshl_b32 s62, s5, 11
  s_add_u32 s62, s62, s7
  s_lshl_b32 s64, s62, 2
  s_lshl_b32 s65, s5, 2
  s_waitcnt lgkmcnt(0)
  s_add_u32 s54, s14, s64
  s_addc_u32 s55, s15, 0
  s_load_dword s56, s[16:17], s65
  s_load_dword s52, s[54:55], 4096
  s_load_dword s48, s[54:55], 0
  s_load_dword s49, s[54:55], 1024
  s_load_dword s50, s[54:55], 2048
  s_load_dword s51, s[54:55], 3072
  s_or_b32 s62, s2, s3
  s_cbranch_scc0 L_mknonce
L_nonced:
  s_and_b32 s77, s3, 1
  s_lshl_b32 s62, s4, 1
  s_add_u32 s77, s77, s62
  v_lshrrev_b32 v5, 1, v3
  v_lshlrev_b32 v6, 10, v5
  v_lshl_add_u32 v6, v4, 5, v6
  v_and_b32 v5, 1, v3
  v_lshl_add_u32 v6, v5, 4, v6
  s_lshl_b32 s66, s77, 8
  v_add_u32 v6, s66, v6
  v_lshlrev_b32 v7, 11, v4
  v_lshl_add_u32 v7, v3, 4, v7
  v_add_u32 v7, s66, v7
  v_and_b32 v5, 7, v3
  v_lshlrev_b32 v14, 8, v5
  v_lshl_add_u32 v14, v4, 5, v14
  v_lshrrev_b32 v5, 3, v3
  v_lshl_add_u32 v14, v5, 4, v14
  s_lshl_b32 s67, s5, 13
  s_lshl_b32 s68, s77, 11
  s_add_u32 s67, s67, s68
  s_mov_b32 s24, s10
  s_mov_b32 s25, s11
  s_mov_b32 s26, 67174400
  s_mov_b32 s27, 0x20000
  s_mov_b32 s36, s8
  s_mov_b32 s37, s9
  s_mov_b32 s38, 16384
  s_mov_b32 s39, 0x20000
  s_movk_i32 s57, 0x2000
  s_mov_b32 s61, s7
  s_waitcnt lgkmcnt(0)
  s_cmp_le_i32 s56, 0
  s_cselect_b32 s67, 0x80000000, s67
  s_cselect_b32 s56, 0x8000, s56
  s_min_i32 s56, s56, 0x8000
  v_add_u32 v14, s67, v14
  buffer_load_dwordx4 v[16:19], v14, s[36:39], 0 offen
  buffer_load_dwordx4 v[20:23], v14, s[36:39], 0 offen offset:128
L_round:
  s_lshl_b32 s62, s61, 4
  s_sub_i32 s62, s56, s62
  s_sub_i32 s71, s62, 16384
  s_lshl_b32 s66, s52, 14
  s_cmp_gt_i32 s71, 0
  s_cselect_b32 s66, s66, 0x80000000
  v_add_u32 v8, s66, v6
  buffer_load_dwordx4 v[96:99], v8, s[24:27], 0 offen offset:0 nt
  buffer_load_dwordx4 v[100:103], v8, s[24:27], 0 offen offset:128 nt
  buffer_load_dwordx4 v[104:107], v8, s[24:27], s57 offen offset:0 nt
  buffer_load_dwordx4 v[108:111], v8, s[24:27], s57 offen offset:128 nt
  s_sub_i32 s72, s62, 0
  s_lshl_b32 s67, s48, 14
  s_cmp_gt_i32 s72, 0
  s_cselect_b32 s67, s67, 0x80000000
  v_add_u32 v8, s67, v6
  buffer_load_dwordx4 v[112:115], v8, s[24:27], 0 offen offset:0 nt
  buffer_load_dwordx4 v[116:119], v8, s[24:27], 0 offen offset:128 nt
  buffer_load_dwordx4 v[120:123], v8, s[24:27], s57 offen offset:0 nt
  buffer_load_dwordx4 v[124:127], v8, s[24:27], s57 offen offset:128 nt
  s_sub_i32 s73, s62, 4096
  s_lshl_b32 s68, s49, 14
  s_cmp_gt_i32 s73, 0
  s_cselect_b32 s68, s68, 0x80000000
  v_add_u32 v8, s68, v6
  buffer_load_dwordx4 v[128:131], v8, s[24:27], 0 offen offset:0 nt
  buffer_load_dwordx4 v[132:135], v8, s[24:27], 0 offen offset:128 nt
  buffer_load_dwordx4 v[136:139], v8, s[24:27], s57 offen offset:0 nt
  buffer_load_dwordx4 v[140:143], v8, s[24:27], s57 offen offset:128 nt
  s_sub_i32 s74, s62, 8192
  s_lshl_b32 s69, s50, 14
  s_cmp_gt_i32 s74, 0
  s_cselect_b32 s69, s69, 0x80000000
  v_add_u32 v8, s69, v6
  buffer_load_dwordx4 v[144:147], v8, s[24:27], 0 offen offset:0 nt
  buffer_load_dwordx4 v[148:151], v8, s[24:27], 0 offen offset:128 nt
  buffer_load_dwordx4 v[152:155], v8, s[24:27], s57 offen offset:0 nt
  buffer_load_dwordx4 v[156:159], v8, s[24:27], s57 offen offset:128 nt
  s_sub_i32 s75, s62, 12288
  s_lshl_b32 s70, s51, 14
  s_cmp_gt_i32 s75, 0
  s_cselect_b32 s70, s70, 0x80000000
  v_add_u32 v8, s70, v6
  buffer_load_dwordx4 v[160:163], v8, s[24:27], 0 offen offset:0 nt
  buffer_load_dwordx4 v[164:167], v8, s[24:27], 0 offen offset:128 nt
  buffer_load_dwordx4 v[168:171], v8, s[24:27], s57 offen offset:0 nt
  buffer_load_dwordx4 v[172:175], v8, s[24:27], s57 offen offset:128 nt
  s_cmp_gt_i32 s62, 20480
  s_cselect_b32 s76, 1, 0
  s_cselect_b32 s63, 0, s3
  s_cmp_ge_u32 s63, 4
  s_cselect_b32 s53, 1, 0
  s_mov_b32 s28, s12
  s_mov_b32 s29, s13
  s_mov_b32 s30, 67174400
  s_mov_b32 s31, 0x20000
  s_mov_b32 s32, s22
  s_mov_b32 s33, s23
  s_mov_b32 s34, 268697600
  s_mov_b32 s35, 0x20000
  s_mov_b32 s40, s18
  s_mov_b32 s41, s19
  s_mov_b32 s42, 16384
  s_mov_b32 s43, 0x20000
  s_mov_b32 s44, s20
  s_mov_b32 s45, s21
  s_mov_b32 s46, 256
  s_mov_b32 s47, 0x20000
  s_mov_b32 s58, 0x3e0293ee
  s_mov_b32 s59, 0x05040100
  s_mov_b32 s60, 0x07060302
  v_lshlrev_b32 v9, 1, v4
  v_or_b32 v10, 1, v9
  v_mov_b32 v11, 0xf149f2ca
  v_mov_b32 v52, 0x3f803f80
  v_mov_b32 v53, v52
  v_mov_b32 v54, v52
  v_mov_b32 v55, v52
  s_and_b32 s64, s3, 1
  s_lshl_b32 s64, s64, 8
  v_lshlrev_b32 v42, 4, v3
  v_add_u32 v42, s64, v42
  s_lshr_b32 s64, s3, 1
  s_lshl_b32 s64, s64, 2
  v_add_u32 v43, s64, v42
  v_and_b32 v1, 0x17f, v42
  v_mov_b32 v5, 0
  s_cmp_lg_u32 s61, s7
  s_cbranch_scc1 L_noinit
  v_mov_b32 v12, v11
  v_mov_b32 v56, 0
  v_mov_b32 v57, 0
  v_mov_b32 v58, 0
  v_mov_b32 v59, 0
  v_mov_b32 v60, 0
  v_mov_b32 v61, 0
  v_mov_b32 v62, 0
  v_mov_b32 v63, 0
  v_mov_b32 v64, 0
  v_mov_b32 v65, 0
  v_mov_b32 v66, 0
  v_mov_b32 v67, 0
  v_mov_b32 v68, 0
  v_mov_b32 v69, 0
  v_mov_b32 v70, 0
  v_mov_b32 v71, 0
  v_mov_b32 v72, 0
  v_mov_b32 v73, 0
  v_mov_b32 v74, 0
  v_mov_b32 v75, 0
  v_mov_b32 v76, 0
  v_mov_b32 v77, 0
  v_mov_b32 v78, 0
  v_mov_b32 v79, 0
  v_mov_b32 v80, 0
  v_mov_b32 v81, 0
  v_mov_b32 v82, 0
  v_mov_b32 v83, 0
  v_mov_b32 v84, 0
  v_mov_b32 v85, 0
  v_mov_b32 v86, 0
  v_mov_b32 v87, 0
  v_mov_b32 v88, 0
  v_mov_b32 v89, 0
  v_mov_b32 v90, 0
  v_mov_b32 v91, 0
L_noinit:
  s_waitcnt vmcnt(16)
  v_mfma_f32_16x16x32_bf16 v[24:27], v[96:99], v[16:19], 0
  v_mfma_f32_16x16x32_bf16 v[28:31], v[104:107], v[16:19], 0
  v_mfma_f32_16x16x32_bf16 v[24:27], v[100:103], v[20:23], v[24:27]
  v_mfma_f32_16x16x32_bf16 v[28:31], v[108:111], v[20:23], v[28:31]
  v_add_u32 v8, s66, v7
  buffer_load_dwordx4 v[176:179], v8, s[28:31], 0 offen offset:0 nt
  buffer_load_dwordx4 v[180:183], v8, s[28:31], 0 offen offset:1024 nt
  buffer_load_dwordx4 v[184:187], v8, s[28:31], s57 offen offset:0 nt
  buffer_load_dwordx4 v[188:191], v8, s[28:31], s57 offen offset:1024 nt
  s_waitcnt vmcnt(16)
  v_mfma_f32_16x16x32_bf16 v[32:35], v[112:115], v[16:19], 0
  v_mfma_f32_16x16x32_bf16 v[36:39], v[120:123], v[16:19], 0
  v_mfma_f32_16x16x32_bf16 v[32:35], v[116:119], v[20:23], v[32:35]
  v_mfma_f32_16x16x32_bf16 v[36:39], v[124:127], v[20:23], v[36:39]
  s_sub_i32 s63, s71, 8
  v_cmp_gt_i32_e64 s[80:81], s71, v9
  v_cmp_gt_i32_e64 s[82:83], s71, v10
  v_add_f32_dpp v96, v25, v24 row_ror:8 row_mask:0xf bank_mask:0xf
  v_add_f32_dpp v97, v27, v26 row_ror:8 row_mask:0xf bank_mask:0xf
  v_add_f32_dpp v98, v29, v28 row_ror:8 row_mask:0xf bank_mask:0xf
  v_add_f32_dpp v99, v31, v30 row_ror:8 row_mask:0xf bank_mask:0xf
  v_mul_f32 v96, s58, v96
  v_mul_f32 v97, s58, v97
  v_cndmask_b32_e64 v96, v11, v96, s[80:81]
  v_cndmask_b32_e64 v97, v11, v97, s[82:83]
  v_cmp_gt_i32_e64 s[80:81], s63, v9
  v_cmp_gt_i32_e64 s[82:83], s63, v10
  v_mul_f32 v98, s58, v98
  v_mul_f32 v99, s58, v99
  v_cndmask_b32_e64 v98, v11, v98, s[80:81]
  v_cndmask_b32_e64 v99, v11, v99, s[82:83]
  v_max3_f32 v14, v96, v97, v98
  v_max_f32 v14, v14, v99
  s_waitcnt vmcnt(12)
  v_mfma_f32_16x16x32_bf16 v[24:27], v[128:131], v[16:19], 0
  v_mfma_f32_16x16x32_bf16 v[28:31], v[136:139], v[16:19], 0
  v_mfma_f32_16x16x32_bf16 v[24:27], v[132:135], v[20:23], v[24:27]
  v_mfma_f32_16x16x32_bf16 v[28:31], v[140:143], v[20:23], v[28:31]
  s_sub_i32 s63, s72, 8
  v_cmp_gt_i32_e64 s[80:81], s72, v9
  v_cmp_gt_i32_e64 s[82:83], s72, v10
  v_add_f32_dpp v112, v33, v32 row_ror:8 row_mask:0xf bank_mask:0xf
  v_add_f32_dpp v113, v35, v34 row_ror:8 row_mask:0xf bank_mask:0xf
  v_add_f32_dpp v114, v37, v36 row_ror:8 row_mask:0xf bank_mask:0xf
  v_add_f32_dpp v115, v39, v38 row_ror:8 row_mask:0xf bank_mask:0xf
  v_mul_f32 v112, s58, v112
  v_mul_f32 v113, s58, v113
  v_cndmask_b32_e64 v112, v11, v112, s[80:81]
  v_cndmask_b32_e64 v113, v11, v113, s[82:83]
  v_cmp_gt_i32_e64 s[80:81], s63, v9
  v_cmp_gt_i32_e64 s[82:83], s63, v10
  v_mul_f32 v114, s58, v114
  v_mul_f32 v115, s58, v115
  v_cndmask_b32_e64 v114, v11, v114, s[80:81]
  v_cndmask_b32_e64 v115, v11, v115, s[82:83]
  v_max3_f32 v14, v14, v112, v113
  v_max3_f32 v14, v14, v114, v115
  v_add_u32 v8, s67, v7
  buffer_load_dwordx4 v[192:195], v8, s[28:31], 0 offen offset:0 nt
  buffer_load_dwordx4 v[196:199], v8, s[28:31], 0 offen offset:1024 nt
  buffer_load_dwordx4 v[200:203], v8, s[28:31], s57 offen offset:0 nt
  buffer_load_dwordx4 v[204:207], v8, s[28:31], s57 offen offset:1024 nt
  s_waitcnt vmcnt(12)
  v_mfma_f32_16x16x32_bf16 v[32:35], v[144:147], v[16:19], 0
  v_mfma_f32_16x16x32_bf16 v[36:39], v[152:155], v[16:19], 0
  v_mfma_f32_16x16x32_bf16 v[32:35], v[148:151], v[20:23], v[32:35]
  v_mfma_f32_16x16x32_bf16 v[36:39], v[156:159], v[20:23], v[36:39]
  s_sub_i32 s63, s73, 8
  v_cmp_gt_i32_e64 s[80:81], s73, v9
  v_cmp_gt_i32_e64 s[82:83], s73, v10
  v_add_f32_dpp v128, v25, v24 row_ror:8 row_mask:0xf bank_mask:0xf
  v_add_f32_dpp v129, v27, v26 row_ror:8 row_mask:0xf bank_mask:0xf
  v_add_f32_dpp v130, v29, v28 row_ror:8 row_mask:0xf bank_mask:0xf
  v_add_f32_dpp v131, v31, v30 row_ror:8 row_mask:0xf bank_mask:0xf
  v_mul_f32 v128, s58, v128
  v_mul_f32 v129, s58, v129
  v_cndmask_b32_e64 v128, v11, v128, s[80:81]
  v_cndmask_b32_e64 v129, v11, v129, s[82:83]
  v_cmp_gt_i32_e64 s[80:81], s63, v9
  v_cmp_gt_i32_e64 s[82:83], s63, v10
  v_mul_f32 v130, s58, v130
  v_mul_f32 v131, s58, v131
  v_cndmask_b32_e64 v130, v11, v130, s[80:81]
  v_cndmask_b32_e64 v131, v11, v131, s[82:83]
  v_max3_f32 v14, v14, v128, v129
  v_max3_f32 v14, v14, v130, v131
  v_add_u32 v8, s68, v7
  buffer_load_dwordx4 v[208:211], v8, s[28:31], 0 offen offset:0 nt
  buffer_load_dwordx4 v[212:215], v8, s[28:31], 0 offen offset:1024 nt
  buffer_load_dwordx4 v[216:219], v8, s[28:31], s57 offen offset:0 nt
  buffer_load_dwordx4 v[220:223], v8, s[28:31], s57 offen offset:1024 nt
  s_waitcnt vmcnt(12)
  v_mfma_f32_16x16x32_bf16 v[24:27], v[160:163], v[16:19], 0
  v_mfma_f32_16x16x32_bf16 v[28:31], v[168:171], v[16:19], 0
  v_mfma_f32_16x16x32_bf16 v[24:27], v[164:167], v[20:23], v[24:27]
  v_mfma_f32_16x16x32_bf16 v[28:31], v[172:175], v[20:23], v[28:31]
  s_sub_i32 s63, s74, 8
  v_cmp_gt_i32_e64 s[80:81], s74, v9
  v_cmp_gt_i32_e64 s[82:83], s74, v10
  v_add_f32_dpp v144, v33, v32 row_ror:8 row_mask:0xf bank_mask:0xf
  v_add_f32_dpp v145, v35, v34 row_ror:8 row_mask:0xf bank_mask:0xf
  v_add_f32_dpp v146, v37, v36 row_ror:8 row_mask:0xf bank_mask:0xf
  v_add_f32_dpp v147, v39, v38 row_ror:8 row_mask:0xf bank_mask:0xf
  v_mul_f32 v144, s58, v144
  v_mul_f32 v145, s58, v145
  v_cndmask_b32_e64 v144, v11, v144, s[80:81]
  v_cndmask_b32_e64 v145, v11, v145, s[82:83]
  v_cmp_gt_i32_e64 s[80:81], s63, v9
  v_cmp_gt_i32_e64 s[82:83], s63, v10
  v_mul_f32 v146, s58, v146
  v_mul_f32 v147, s58, v147
  v_cndmask_b32_e64 v146, v11, v146, s[80:81]
  v_cndmask_b32_e64 v147, v11, v147, s[82:83]
  v_max3_f32 v14, v14, v144, v145
  v_max3_f32 v14, v14, v146, v147
  v_add_u32 v8, s69, v7
  buffer_load_dwordx4 v[224:227], v8, s[28:31], 0 offen offset:0 nt
  buffer_load_dwordx4 v[228:231], v8, s[28:31], 0 offen offset:1024 nt
  buffer_load_dwordx4 v[232:235], v8, s[28:31], s57 offen offset:0 nt
  buffer_load_dwordx4 v[236:239], v8, s[28:31], s57 offen offset:1024 nt
  s_sub_i32 s63, s75, 8
  v_cmp_gt_i32_e64 s[80:81], s75, v9
  v_cmp_gt_i32_e64 s[82:83], s75, v10
  v_add_f32_dpp v160, v25, v24 row_ror:8 row_mask:0xf bank_mask:0xf
  v_add_f32_dpp v161, v27, v26 row_ror:8 row_mask:0xf bank_mask:0xf
  v_add_f32_dpp v162, v29, v28 row_ror:8 row_mask:0xf bank_mask:0xf
  v_add_f32_dpp v163, v31, v30 row_ror:8 row_mask:0xf bank_mask:0xf
  v_mul_f32 v160, s58, v160
  v_mul_f32 v161, s58, v161
  v_cndmask_b32_e64 v160, v11, v160, s[80:81]
  v_cndmask_b32_e64 v161, v11, v161, s[82:83]
  v_cmp_gt_i32_e64 s[80:81], s63, v9
  v_cmp_gt_i32_e64 s[82:83], s63, v10
  v_mul_f32 v162, s58, v162
  v_mul_f32 v163, s58, v163
  v_cndmask_b32_e64 v162, v11, v162, s[80:81]
  v_cndmask_b32_e64 v163, v11, v163, s[82:83]
  v_max3_f32 v14, v14, v160, v161
  v_max3_f32 v14, v14, v162, v163
  v_mov_b32 v15, v14
  s_nop 1
  v_permlane16_swap_b32 v14, v15
  v_max_f32 v14, v14, v15
  v_mov_b32 v15, v14
  s_nop 1
  v_permlane32_swap_b32 v14, v15
  v_max3_f32 v13, v14, v15, v12
  s_cmp_eq_u32 s53, 0
  s_cbranch_scc1 L_ownmax
  ds_write_b32 v43, v13 offset:64
  s_waitcnt lgkmcnt(0)
  s_barrier
  ds_read_b128 v[100:103], v42 offset:64
  ds_read_b64 v[92:93], v5 offset:0
  s_waitcnt lgkmcnt(1)
  v_max3_f32 v13, v100, v101, v102
  v_max_f32 v13, v13, v103
  s_waitcnt lgkmcnt(0)
  v_readfirstlane_b32 s84, v92
  v_readfirstlane_b32 s85, v93
L_ownmax:
  s_cmp_lg_u32 s61, s7
  s_cbranch_scc1 L_rescale
L_rescaled:
  v_mov_b32 v12, v13
  v_add_u32 v8, s70, v7
  buffer_load_dwordx4 v[240:243], v8, s[28:31], 0 offen offset:0 nt
  buffer_load_dwordx4 v[244:247], v8, s[28:31], 0 offen offset:1024 nt
  buffer_load_dwordx4 v[248:251], v8, s[28:31], s57 offen offset:0 nt
  buffer_load_dwordx4 v[252:255], v8, s[28:31], s57 offen offset:1024 nt
  v_sub_f32 v96, v96, v13
  v_sub_f32 v97, v97, v13
  v_sub_f32 v98, v98, v13
  v_sub_f32 v99, v99, v13
  v_exp_f32 v96, v96
  v_exp_f32 v97, v97
  v_exp_f32 v98, v98
  v_exp_f32 v99, v99
  v_sub_f32 v112, v112, v13
  v_sub_f32 v113, v113, v13
  v_sub_f32 v114, v114, v13
  v_sub_f32 v115, v115, v13
  v_exp_f32 v112, v112
  v_exp_f32 v113, v113
  v_exp_f32 v114, v114
  v_exp_f32 v115, v115
  v_cvt_pk_bf16_f32 v40, v96, v97
  v_cvt_pk_bf16_f32 v41, v98, v99
  v_sub_f32 v128, v128, v13
  v_sub_f32 v129, v129, v13
  v_sub_f32 v130, v130, v13
  v_sub_f32 v131, v131, v13
  v_exp_f32 v128, v128
  v_exp_f32 v129, v129
  v_exp_f32 v130, v130
  v_exp_f32 v131, v131
  v_cvt_pk_bf16_f32 v44, v112, v113
  v_cvt_pk_bf16_f32 v45, v114, v115
  v_sub_f32 v144, v144, v13
  v_sub_f32 v145, v145, v13
  v_sub_f32 v146, v146, v13
  v_sub_f32 v147, v147, v13
  v_exp_f32 v144, v144
  v_exp_f32 v145, v145
  v_exp_f32 v146, v146
  v_exp_f32 v147, v147
  v_cvt_pk_bf16_f32 v46, v128, v129
  v_cvt_pk_bf16_f32 v47, v130, v131
  v_sub_f32 v160, v160, v13
  v_sub_f32 v161, v161, v13
  v_sub_f32 v162, v162, v13
  v_sub_f32 v163, v163, v13
  v_exp_f32 v160, v160
  v_exp_f32 v161, v161
  v_exp_f32 v162, v162
  v_exp_f32 v163, v163
  v_cvt_pk_bf16_f32 v48, v144, v145
  v_cvt_pk_bf16_f32 v49, v146, v147
  v_mfma_f32_16x16x16_bf16 v[88:91], v[52:53], v[40:41], v[88:91]
  v_cvt_pk_bf16_f32 v50, v160, v161
  v_cvt_pk_bf16_f32 v51, v162, v163
  v_lshlrev_b32 v33, 4, v2
  s_and_b32 s62, s3, 3
  s_lshl_b32 s63, s62, 11
  v_add_u32 v37, s63, v33
  v_xor_b32 v32, 0x1000, v37
  s_lshl_b32 s63, s62, 12
  v_add_u32 v39, s63, v33
  s_lshl_b32 s62, s62, 2
  v_mov_b32 v36, s62
  v_xor_b32 v15, 8, v36
  s_and_b32 s62, s3, 1
  s_bfe_u32 s64, s3, 0x10001
  s_lshl_b32 s63, s62, 12
  s_lshl_b32 s65, s64, 11
  s_add_u32 s63, s63, s65
  v_add_u32 v38, s63, v33
  s_and_b32 s65, s2, 3
  s_mul_i32 s65, s65, 524288
  s_lshl_b32 s66, s6, 13
  s_add_u32 s65, s65, s66
  v_add_u32 v34, s65, v38
  s_movk_i32 s80, 0xf000
  v_mfma_f32_16x16x32_bf16 v[88:91], v[52:55], v[44:47], v[88:91]
  v_mfma_f32_16x16x32_bf16 v[88:91], v[52:55], v[48:51], v[88:91]
  s_waitcnt vmcnt(16)
  v_perm_b32 v96, v180, v176, s59
  v_perm_b32 v97, v188, v184, s59
  v_perm_b32 v98, v180, v176, s60
  v_perm_b32 v99, v188, v184, s60
  v_perm_b32 v100, v181, v177, s59
  v_perm_b32 v101, v189, v185, s59
  v_perm_b32 v102, v181, v177, s60
  v_perm_b32 v103, v189, v185, s60
  v_perm_b32 v104, v182, v178, s59
  v_perm_b32 v105, v190, v186, s59
  v_perm_b32 v106, v182, v178, s60
  v_perm_b32 v107, v190, v186, s60
  v_perm_b32 v108, v183, v179, s59
  v_perm_b32 v109, v191, v187, s59
  v_perm_b32 v110, v183, v179, s60
  v_perm_b32 v111, v191, v187, s60
  s_cmp_eq_u32 s53, 0
  s_cbranch_scc1 L_nolw
  ds_write_b32 v43, v88 offset:576
L_nolw:
  v_mfma_f32_16x16x16_bf16 v[56:59], v[96:97], v[40:41], v[56:59]
  v_mfma_f32_16x16x16_bf16 v[60:63], v[98:99], v[40:41], v[60:63]
  v_mfma_f32_16x16x16_bf16 v[64:67], v[100:101], v[40:41], v[64:67]
  v_mfma_f32_16x16x16_bf16 v[68:71], v[102:103], v[40:41], v[68:71]
  v_mfma_f32_16x16x16_bf16 v[72:75], v[104:105], v[40:41], v[72:75]
  v_mfma_f32_16x16x16_bf16 v[76:79], v[106:107], v[40:41], v[76:79]
  v_mfma_f32_16x16x16_bf16 v[80:83], v[108:109], v[40:41], v[80:83]
  v_mfma_f32_16x16x16_bf16 v[84:87], v[110:111], v[40:41], v[84:87]
  v_and_b32 v31, 2, v2
  v_cmp_eq_u32 vcc, 0, v31
  v_mov_b32 v29, s84
  v_mov_b32 v31, s85
  v_cndmask_b32 v29, v31, v29, vcc
  v_and_b32 v31, 1, v2
  v_lshlrev_b32 v31, 2, v31
  v_lshrrev_b32 v29, v31, v29
  v_and_b32 v29, 0x0f0f0f0f, v29
  v_mov_b32 v30, v12
  v_mov_b32_dpp v30, v12 row_ror:8 row_mask:0xf bank_mask:0xc
  s_waitcnt vmcnt(12)
  v_perm_b32 v112, v196, v192, s59
  v_perm_b32 v113, v204, v200, s59
  v_perm_b32 v116, v196, v192, s60
  v_perm_b32 v117, v204, v200, s60
  v_perm_b32 v120, v197, v193, s59
  v_perm_b32 v121, v205, v201, s59
  v_perm_b32 v124, v197, v193, s60
  v_perm_b32 v125, v205, v201, s60
  v_perm_b32 v128, v198, v194, s59
  v_perm_b32 v129, v206, v202, s59
  v_perm_b32 v132, v198, v194, s60
  v_perm_b32 v133, v206, v202, s60
  v_perm_b32 v136, v199, v195, s59
  v_perm_b32 v137, v207, v203, s59
  v_perm_b32 v140, v199, v195, s60
  v_perm_b32 v141, v207, v203, s60
  s_waitcnt vmcnt(8)
  s_cmp_eq_u32 s53, 0
  s_cbranch_scc1 L_nob1
  s_waitcnt lgkmcnt(0)
  s_barrier
  ds_read_b128 v[92:95], v1 offset:576
  ds_read_b128 v[176:179], v38 offset:10240
  ds_read_b128 v[180:183], v38 offset:11264
  ds_read_b128 v[184:187], v38 offset:18432
  ds_read_b128 v[188:191], v38 offset:19456
L_nob1:
  v_perm_b32 v114, v212, v208, s59
  v_perm_b32 v115, v220, v216, s59
  v_perm_b32 v118, v212, v208, s60
  v_perm_b32 v119, v220, v216, s60
  v_perm_b32 v122, v213, v209, s59
  v_perm_b32 v123, v221, v217, s59
  v_perm_b32 v126, v213, v209, s60
  v_perm_b32 v127, v221, v217, s60
  v_perm_b32 v130, v214, v210, s59
  v_perm_b32 v131, v222, v218, s59
  v_perm_b32 v134, v214, v210, s60
  v_perm_b32 v135, v222, v218, s60
  v_perm_b32 v138, v215, v211, s59
  v_perm_b32 v139, v223, v219, s59
  v_perm_b32 v142, v215, v211, s60
  v_perm_b32 v143, v223, v219, s60
  v_mfma_f32_16x16x32_bf16 v[56:59], v[112:115], v[44:47], v[56:59]
  v_mfma_f32_16x16x32_bf16 v[60:63], v[116:119], v[44:47], v[60:63]
  v_mfma_f32_16x16x32_bf16 v[64:67], v[120:123], v[44:47], v[64:67]
  v_mfma_f32_16x16x32_bf16 v[68:71], v[124:127], v[44:47], v[68:71]
  v_mfma_f32_16x16x32_bf16 v[72:75], v[128:131], v[44:47], v[72:75]
  v_mfma_f32_16x16x32_bf16 v[76:79], v[132:135], v[44:47], v[76:79]
  v_mfma_f32_16x16x32_bf16 v[80:83], v[136:139], v[44:47], v[80:83]
  v_mfma_f32_16x16x32_bf16 v[84:87], v[140:143], v[44:47], v[84:87]
  s_waitcnt vmcnt(4)
  v_perm_b32 v144, v228, v224, s59
  v_perm_b32 v145, v236, v232, s59
  v_perm_b32 v148, v228, v224, s60
  v_perm_b32 v149, v236, v232, s60
  v_perm_b32 v152, v229, v225, s59
  v_perm_b32 v153, v237, v233, s59
  v_perm_b32 v156, v229, v225, s60
  v_perm_b32 v157, v237, v233, s60
  v_perm_b32 v160, v230, v226, s59
  v_perm_b32 v161, v238, v234, s59
  v_perm_b32 v164, v230, v226, s60
  v_perm_b32 v165, v238, v234, s60
  v_perm_b32 v168, v231, v227, s59
  v_perm_b32 v169, v239, v235, s59
  v_perm_b32 v172, v231, v227, s60
  v_perm_b32 v173, v239, v235, s60
  s_cmp_eq_u32 s53, 0
  s_cbranch_scc1 L_tail_other
  s_mov_b32 s86, 0xc0c0400
  s_mov_b32 s87, 0xc0c0501
  s_mov_b32 s88, 0xc0c0602
  s_mov_b32 s89, 0xc0c0703
  s_waitcnt lgkmcnt(4)
  v_add_f32 v92, v92, v93
  v_add_f32 v94, v94, v95
  v_add_f32 v92, v92, v94
  v_rcp_f32 v28, v92
  v_log_f32 v31, v92
  v_mov_b32 v14, 1
  s_waitcnt lgkmcnt(0)
  v_add_f32 v176, v176, v184
  v_add_f32 v177, v177, v185
  v_add_f32 v178, v178, v186
  v_add_f32 v179, v179, v187
  v_add_f32 v180, v180, v188
  v_add_f32 v181, v181, v189
  v_add_f32 v182, v182, v190
  v_add_f32 v183, v183, v191
  v_add_f32 v30, v30, v31
  v_mul_f32 v176, v176, v28
  v_mul_f32 v177, v177, v28
  v_mul_f32 v178, v178, v28
  v_mul_f32 v179, v179, v28
  v_mul_f32 v180, v180, v28
  v_mul_f32 v181, v181, v28
  v_mul_f32 v182, v182, v28
  v_mul_f32 v183, v183, v28
  v_perm_b32 v24, v29, v30, s86
  v_perm_b32 v25, v29, v30, s87
  v_perm_b32 v26, v29, v30, s88
  v_perm_b32 v27, v29, v30, s89
  s_cmp_ge_u32 s3, 6
  s_cbranch_scc1 L_tail_e1
  s_waitcnt vmcnt(0)
  v_perm_b32 v162, v246, v242, s59
  v_perm_b32 v163, v254, v250, s59
  v_perm_b32 v166, v246, v242, s60
  v_perm_b32 v167, v254, v250, s60
  v_perm_b32 v170, v247, v243, s59
  v_perm_b32 v171, v255, v251, s59
  v_mfma_f32_16x16x32_bf16 v[72:75], v[160:163], v[48:51], v[72:75]
  v_perm_b32 v174, v247, v243, s60
  v_perm_b32 v175, v255, v251, s60
  v_mfma_f32_16x16x32_bf16 v[76:79], v[164:167], v[48:51], v[76:79]
  v_perm_b32 v146, v244, v240, s59
  v_perm_b32 v147, v252, v248, s59
  v_mfma_f32_16x16x32_bf16 v[80:83], v[168:171], v[48:51], v[80:83]
  v_perm_b32 v150, v244, v240, s60
  v_perm_b32 v151, v252, v248, s60
  v_mfma_f32_16x16x32_bf16 v[84:87], v[172:175], v[48:51], v[84:87]
  v_perm_b32 v154, v245, v241, s59
  v_perm_b32 v155, v253, v249, s59
  v_mfma_f32_16x16x32_bf16 v[56:59], v[144:147], v[48:51], v[56:59]
  v_mov_b32_dpp v72, v76 row_ror:8 row_mask:0xf bank_mask:0xc
  v_mov_b32_dpp v73, v77 row_ror:8 row_mask:0xf bank_mask:0xc
  v_mov_b32_dpp v74, v78 row_ror:8 row_mask:0xf bank_mask:0xc
  v_mov_b32_dpp v75, v79 row_ror:8 row_mask:0xf bank_mask:0xc
  ds_write_b128 v37, v[72:75] offset:2048
  v_perm_b32 v158, v245, v241, s60
  v_perm_b32 v159, v253, v249, s60
  v_mfma_f32_16x16x32_bf16 v[60:63], v[148:151], v[48:51], v[60:63]
  v_mfma_f32_16x16x32_bf16 v[64:67], v[152:155], v[48:51], v[64:67]
  v_mov_b32_dpp v80, v84 row_ror:8 row_mask:0xf bank_mask:0xc
  v_mov_b32_dpp v81, v85 row_ror:8 row_mask:0xf bank_mask:0xc
  v_mov_b32_dpp v82, v86 row_ror:8 row_mask:0xf bank_mask:0xc
  v_mov_b32_dpp v83, v87 row_ror:8 row_mask:0xf bank_mask:0xc
  v_mfma_f32_16x16x32_bf16 v[68:71], v[156:159], v[48:51], v[68:71]
  ds_write_b128 v37, v[80:83] offset:3072
  ds_write_b32 v36, v14 offset:16
  ds_read_b32 v14, v15 offset:16
  ds_read_b128 v[96:99], v32 offset:2048
  ds_read_b128 v[100:103], v32 offset:3072
  v_mov_b32_dpp v56, v60 row_ror:8 row_mask:0xf bank_mask:0xc
  v_mov_b32_dpp v57, v61 row_ror:8 row_mask:0xf bank_mask:0xc
  v_mov_b32_dpp v58, v62 row_ror:8 row_mask:0xf bank_mask:0xc
  v_mov_b32_dpp v59, v63 row_ror:8 row_mask:0xf bank_mask:0xc
  v_fmac_f32 v176, v56, v28
  v_fmac_f32 v177, v57, v28
  v_fmac_f32 v178, v58, v28
  v_fmac_f32 v179, v59, v28
  v_mov_b32_dpp v64, v68 row_ror:8 row_mask:0xf bank_mask:0xc
  v_mov_b32_dpp v65, v69 row_ror:8 row_mask:0xf bank_mask:0xc
  v_mov_b32_dpp v66, v70 row_ror:8 row_mask:0xf bank_mask:0xc
  v_mov_b32_dpp v67, v71 row_ror:8 row_mask:0xf bank_mask:0xc
  v_fmac_f32 v180, v64, v28
  v_fmac_f32 v181, v65, v28
  v_fmac_f32 v182, v66, v28
  v_fmac_f32 v183, v67, v28
  s_waitcnt lgkmcnt(2)
  v_cmp_eq_u32 vcc, 0, v14
  s_cbranch_vccz L_paired0
L_pair0:
  ds_read_b32 v14, v15 offset:16
  ds_read_b128 v[96:99], v32 offset:2048
  ds_read_b128 v[100:103], v32 offset:3072
  s_waitcnt lgkmcnt(2)
  v_cmp_eq_u32 vcc, 0, v14
  s_cbranch_vccnz L_pair0
L_paired0:
  s_waitcnt lgkmcnt(1)
  v_fmac_f32 v176, v96, v28
  v_fmac_f32 v177, v97, v28
  v_fmac_f32 v178, v98, v28
  v_fmac_f32 v179, v99, v28
  v_and_or_b32 v176, v176, s80, v24
  v_and_or_b32 v177, v177, s80, v25
  v_and_or_b32 v178, v178, s80, v26
  v_and_or_b32 v179, v179, s80, v27
  buffer_store_dwordx4 v[176:179], v34, s[32:35], 0 offen offset:0 sc0 sc1
  s_waitcnt lgkmcnt(0)
  v_fmac_f32 v180, v100, v28
  v_fmac_f32 v181, v101, v28
  v_fmac_f32 v182, v102, v28
  v_fmac_f32 v183, v103, v28
  v_and_or_b32 v180, v180, s80, v24
  v_and_or_b32 v181, v181, s80, v25
  v_and_or_b32 v182, v182, s80, v26
  v_and_or_b32 v183, v183, s80, v27
  buffer_store_dwordx4 v[180:183], v34, s[32:35], 0 offen offset:1024 sc0 sc1
  s_endpgm
L_tail_e1:
  s_waitcnt vmcnt(0)
  v_perm_b32 v146, v244, v240, s59
  v_perm_b32 v147, v252, v248, s59
  v_perm_b32 v150, v244, v240, s60
  v_perm_b32 v151, v252, v248, s60
  v_perm_b32 v154, v245, v241, s59
  v_perm_b32 v155, v253, v249, s59
  v_mfma_f32_16x16x32_bf16 v[56:59], v[144:147], v[48:51], v[56:59]
  v_perm_b32 v158, v245, v241, s60
  v_perm_b32 v159, v253, v249, s60
  v_mfma_f32_16x16x32_bf16 v[60:63], v[148:151], v[48:51], v[60:63]
  v_perm_b32 v162, v246, v242, s59
  v_perm_b32 v163, v254, v250, s59
  v_mfma_f32_16x16x32_bf16 v[64:67], v[152:155], v[48:51], v[64:67]
  v_perm_b32 v166, v246, v242, s60
  v_perm_b32 v167, v254, v250, s60
  v_mfma_f32_16x16x32_bf16 v[68:71], v[156:159], v[48:51], v[68:71]
  v_perm_b32 v170, v247, v243, s59
  v_perm_b32 v171, v255, v251, s59
  v_mfma_f32_16x16x32_bf16 v[72:75], v[160:163], v[48:51], v[72:75]
  v_mov_b32_dpp v56, v60 row_ror:8 row_mask:0xf bank_mask:0xc
  v_mov_b32_dpp v57, v61 row_ror:8 row_mask:0xf bank_mask:0xc
  v_mov_b32_dpp v58, v62 row_ror:8 row_mask:0xf bank_mask:0xc
  v_mov_b32_dpp v59, v63 row_ror:8 row_mask:0xf bank_mask:0xc
  ds_write_b128 v37, v[56:59] offset:2048
  v_perm_b32 v174, v247, v243, s60
  v_perm_b32 v175, v255, v251, s60
  v_mfma_f32_16x16x32_bf16 v[76:79], v[164:167], v[48:51], v[76:79]
  v_mfma_f32_16x16x32_bf16 v[80:83], v[168:171], v[48:51], v[80:83]
  v_mov_b32_dpp v64, v68 row_ror:8 row_mask:0xf bank_mask:0xc
  v_mov_b32_dpp v65, v69 row_ror:8 row_mask:0xf bank_mask:0xc
  v_mov_b32_dpp v66, v70 row_ror:8 row_mask:0xf bank_mask:0xc
  v_mov_b32_dpp v67, v71 row_ror:8 row_mask:0xf bank_mask:0xc
  v_mfma_f32_16x16x32_bf16 v[84:87], v[172:175], v[48:51], v[84:87]
  ds_write_b128 v37, v[64:67] offset:3072
  ds_write_b32 v36, v14 offset:16
  ds_read_b32 v14, v15 offset:16
  ds_read_b128 v[96:99], v32 offset:2048
  ds_read_b128 v[100:103], v32 offset:3072
  v_mov_b32_dpp v72, v76 row_ror:8 row_mask:0xf bank_mask:0xc
  v_mov_b32_dpp v73, v77 row_ror:8 row_mask:0xf bank_mask:0xc
  v_mov_b32_dpp v74, v78 row_ror:8 row_mask:0xf bank_mask:0xc
  v_mov_b32_dpp v75, v79 row_ror:8 row_mask:0xf bank_mask:0xc
  v_fmac_f32 v176, v72, v28
  v_fmac_f32 v177, v73, v28
  v_fmac_f32 v178, v74, v28
  v_fmac_f32 v179, v75, v28
  v_mov_b32_dpp v80, v84 row_ror:8 row_mask:0xf bank_mask:0xc
  v_mov_b32_dpp v81, v85 row_ror:8 row_mask:0xf bank_mask:0xc
  v_mov_b32_dpp v82, v86 row_ror:8 row_mask:0xf bank_mask:0xc
  v_mov_b32_dpp v83, v87 row_ror:8 row_mask:0xf bank_mask:0xc
  v_fmac_f32 v180, v80, v28
  v_fmac_f32 v181, v81, v28
  v_fmac_f32 v182, v82, v28
  v_fmac_f32 v183, v83, v28
  s_waitcnt lgkmcnt(2)
  v_cmp_eq_u32 vcc, 0, v14
  s_cbranch_vccz L_paired1
L_pair1:
  ds_read_b32 v14, v15 offset:16
  ds_read_b128 v[96:99], v32 offset:2048
  ds_read_b128 v[100:103], v32 offset:3072
  s_waitcnt lgkmcnt(2)
  v_cmp_eq_u32 vcc, 0, v14
  s_cbranch_vccnz L_pair1
L_paired1:
  s_waitcnt lgkmcnt(1)
  v_fmac_f32 v176, v96, v28
  v_fmac_f32 v177, v97, v28
  v_fmac_f32 v178, v98, v28
  v_fmac_f32 v179, v99, v28
  v_and_or_b32 v176, v176, s80, v24
  v_and_or_b32 v177, v177, s80, v25
  v_and_or_b32 v178, v178, s80, v26
  v_and_or_b32 v179, v179, s80, v27
  buffer_store_dwordx4 v[176:179], v34, s[32:35], 0 offen offset:0 sc0 sc1
  s_waitcnt lgkmcnt(0)
  v_fmac_f32 v180, v100, v28
  v_fmac_f32 v181, v101, v28
  v_fmac_f32 v182, v102, v28
  v_fmac_f32 v183, v103, v28
  v_and_or_b32 v180, v180, s80, v24
  v_and_or_b32 v181, v181, s80, v25
  v_and_or_b32 v182, v182, s80, v26
  v_and_or_b32 v183, v183, s80, v27
  buffer_store_dwordx4 v[180:183], v34, s[32:35], 0 offen offset:1024 sc0 sc1
  s_endpgm
L_tail_other:
  s_waitcnt vmcnt(0)
  v_perm_b32 v146, v244, v240, s59
  v_perm_b32 v147, v252, v248, s59
  v_perm_b32 v150, v244, v240, s60
  v_perm_b32 v151, v252, v248, s60
  v_perm_b32 v154, v245, v241, s59
  v_perm_b32 v155, v253, v249, s59
  v_mfma_f32_16x16x32_bf16 v[56:59], v[144:147], v[48:51], v[56:59]
  v_perm_b32 v158, v245, v241, s60
  v_perm_b32 v159, v253, v249, s60
  v_mfma_f32_16x16x32_bf16 v[60:63], v[148:151], v[48:51], v[60:63]
  v_perm_b32 v162, v246, v242, s59
  v_perm_b32 v163, v254, v250, s59
  v_mfma_f32_16x16x32_bf16 v[64:67], v[152:155], v[48:51], v[64:67]
  v_perm_b32 v166, v246, v242, s60
  v_perm_b32 v167, v254, v250, s60
  v_mfma_f32_16x16x32_bf16 v[68:71], v[156:159], v[48:51], v[68:71]
  v_perm_b32 v170, v247, v243, s59
  v_perm_b32 v171, v255, v251, s59
  v_mfma_f32_16x16x32_bf16 v[72:75], v[160:163], v[48:51], v[72:75]
  v_perm_b32 v174, v247, v243, s60
  v_perm_b32 v175, v255, v251, s60
  v_mfma_f32_16x16x32_bf16 v[76:79], v[164:167], v[48:51], v[76:79]
  v_mfma_f32_16x16x32_bf16 v[80:83], v[168:171], v[48:51], v[80:83]
  v_mfma_f32_16x16x32_bf16 v[84:87], v[172:175], v[48:51], v[84:87]
  s_cmp_lg_u32 s76, 0
  s_cbranch_scc1 L_again
  ds_write_b32 v43, v12 offset:64
  ds_write_b32 v36, v5 offset:16
  v_mov_b32_dpp v56, v60 row_ror:8 row_mask:0xf bank_mask:0xc
  v_mov_b32_dpp v57, v61 row_ror:8 row_mask:0xf bank_mask:0xc
  v_mov_b32_dpp v58, v62 row_ror:8 row_mask:0xf bank_mask:0xc
  v_mov_b32_dpp v59, v63 row_ror:8 row_mask:0xf bank_mask:0xc
  v_mov_b32_dpp v64, v68 row_ror:8 row_mask:0xf bank_mask:0xc
  v_mov_b32_dpp v65, v69 row_ror:8 row_mask:0xf bank_mask:0xc
  v_mov_b32_dpp v66, v70 row_ror:8 row_mask:0xf bank_mask:0xc
  v_mov_b32_dpp v67, v71 row_ror:8 row_mask:0xf bank_mask:0xc
  v_mov_b32_dpp v72, v76 row_ror:8 row_mask:0xf bank_mask:0xc
  v_mov_b32_dpp v73, v77 row_ror:8 row_mask:0xf bank_mask:0xc
  v_mov_b32_dpp v74, v78 row_ror:8 row_mask:0xf bank_mask:0xc
  v_mov_b32_dpp v75, v79 row_ror:8 row_mask:0xf bank_mask:0xc
  v_mov_b32_dpp v80, v84 row_ror:8 row_mask:0xf bank_mask:0xc
  v_mov_b32_dpp v81, v85 row_ror:8 row_mask:0xf bank_mask:0xc
  v_mov_b32_dpp v82, v86 row_ror:8 row_mask:0xf bank_mask:0xc
  v_mov_b32_dpp v83, v87 row_ror:8 row_mask:0xf bank_mask:0xc
  s_cmp_ge_u32 s3, 3
  s_cbranch_scc1 L_eA
  s_and_b32 s62, s2, 3
  s_mul_i32 s63, s62, 4352
  s_add_u32 s63, s63, 2228224
  v_mov_b32 v99, s63
  s_mul_i32 s63, s62, 524288
  s_lshl_b32 s64, s6, 7
  s_add_u32 s63, s63, s64
  s_lshl_b32 s64, s3, 6
  s_add_u32 s63, s63, s64
  v_lshrrev_b32 v124, 2, v2
  v_and_b32 v125, 3, v2
  v_lshlrev_b32 v96, 13, v124
  v_lshl_add_u32 v96, v125, 4, v96
  v_add_u32 v96, s63, v96
  s_mov_b32 s8, 0x20000
  s_mov_b32 s9, 0x40000
  s_mov_b32 s10, 0x60000
  s_mov_b32 s11, 0x05010400
  s_lshr_b32 s64, s6, 5
  s_lshl_b32 s67, s4, 1
  s_add_u32 s67, s67, s64
  s_lshl_b32 s67, s67, 3
  s_lshl_b32 s66, s3, 2
  s_add_u32 s67, s67, s66
  s_lshr_b32 s66, s2, 1
  s_xor_b32 s66, s66, s64
  s_and_b32 s66, s66, 1
  s_lshl_b32 s66, s66, 5
  s_add_u32 s67, s67, s66
  s_lshl_b32 s67, s67, 7
  s_bfe_u32 s66, s6, 0x20001
  s_lshl_b32 s66, s66, 5
  s_add_u32 s67, s67, s66
  s_bfe_u32 s66, s6, 0x20003
  s_lshl_b32 s66, s66, 1
  s_add_u32 s67, s67, s66
  s_and_b32 s66, s6, 1
  s_add_u32 s67, s67, s66
  v_lshlrev_b32 v98, 7, v125
  v_lshrrev_b32 v124, 4, v2
  v_lshl_add_u32 v98, v124, 3, v98
  v_add_u32 v98, s67, v98
  v_lshlrev_b32 v98, 1, v98
  s_cmp_eq_u32 s3, 2
  s_cbranch_scc1 L_eA
  s_mov_b64 exec, 1
  s_mov_b32 s72, 0x100000
L_getnonce:
  buffer_load_dwordx2 v[92:93], v5, s[44:47], 0 offen offset:192 sc1
  s_sub_u32 s72, s72, 1
  s_cbranch_scc1 L_gotnonce
  s_waitcnt vmcnt(0)
  v_cmp_eq_u32 vcc, 0, v93
  s_cbranch_vccnz L_getnonce
L_gotnonce:
  s_waitcnt vmcnt(0)
  v_readfirstlane_b32 s84, v92
  v_readfirstlane_b32 s85, v93
  ds_write_b64 v5, v[92:93] offset:0
  s_mov_b64 exec, -1
  v_and_b32 v124, 2, v2
  v_cmp_eq_u32 vcc, 0, v124
  v_mov_b32 v97, s84
  v_mov_b32 v124, s85
  v_cndmask_b32 v97, v124, v97, vcc
  v_and_b32 v124, 1, v2
  v_lshlrev_b32 v124, 2, v124
  v_lshrrev_b32 v97, v124, v97
  v_and_b32 v97, 0x0f0f0f0f, v97
L_eA:
  v_mov_b32 v94, 1
  s_waitcnt lgkmcnt(0)
  s_barrier
  ds_read_b128 v[16:19], v1 offset:64
  ds_read_b32 v95, v5 offset:4
  s_waitcnt lgkmcnt(1)
  v_max3_f32 v14, v16, v17, v18
  v_max_f32 v14, v14, v19
  v_sub_f32 v14, v30, v14
  v_exp_f32 v14, v14
  s_nop 0
  v_mul_f32 v88, v88, v14
  ds_write_b32 v43, v88 offset:576
  v_mul_f32 v56, v56, v14
  v_mul_f32 v57, v57, v14
  v_mul_f32 v58, v58, v14
  v_mul_f32 v59, v59, v14
  ds_write_b128 v39, v[56:59] offset:10240
  v_mul_f32 v64, v64, v14
  v_mul_f32 v65, v65, v14
  v_mul_f32 v66, v66, v14
  v_mul_f32 v67, v67, v14
  ds_write_b128 v39, v[64:67] offset:11264
  v_mul_f32 v72, v72, v14
  v_mul_f32 v73, v73, v14
  v_mul_f32 v74, v74, v14
  v_mul_f32 v75, v75, v14
  ds_write_b128 v39, v[72:75] offset:12288
  v_mul_f32 v80, v80, v14
  v_mul_f32 v81, v81, v14
  v_mul_f32 v82, v82, v14
  v_mul_f32 v83, v83, v14
  ds_write_b128 v39, v[80:83] offset:13312
  s_waitcnt lgkmcnt(0)
  s_barrier
  s_cmp_ge_u32 s3, 3
  s_cbranch_scc1 L_fin
  s_cmp_eq_u32 s3, 2
  s_cbranch_scc1 L_w2
  s_mov_b32 s72, 0x100000
  s_mov_b64 exec, 1
L_c_flag:
  buffer_load_dword v124, v99, s[32:35], 0 offen offset:2048 sc1
  s_sub_u32 s72, s72, 1
  s_cbranch_scc1 L_c_end
  s_waitcnt vmcnt(0)
  v_cmp_eq_u32 vcc, s85, v124
  s_cbranch_vccz L_c_flag
L_c_go:
  s_mov_b64 exec, -1
  buffer_load_dwordx4 v[104:107], v96, s[32:35], 0 offen sc1
  buffer_load_dwordx4 v[108:111], v96, s[32:35], s8 offen sc1
  buffer_load_dwordx4 v[112:115], v96, s[32:35], s9 offen sc1
  buffer_load_dwordx4 v[116:119], v96, s[32:35], s10 offen sc1
  s_waitcnt vmcnt(3)
  v_perm_b32 v124, v105, v104, s11
  v_perm_b32 v125, v107, v106, s11
  v_perm_b32 v126, v125, v124, s60
  v_perm_b32 v100, v125, v124, s59
  v_and_b32 v126, 0x0f0f0f0f, v126
  v_cmp_ne_u32_e64 s[64:65], v126, v97
  v_and_b32 v104, s80, v104
  v_and_b32 v105, s80, v105
  v_and_b32 v106, s80, v106
  v_and_b32 v107, s80, v107
  s_waitcnt vmcnt(2)
  v_perm_b32 v124, v109, v108, s11
  v_perm_b32 v125, v111, v110, s11
  v_perm_b32 v126, v125, v124, s60
  v_perm_b32 v101, v125, v124, s59
  v_and_b32 v126, 0x0f0f0f0f, v126
  v_cmp_ne_u32_e64 s[66:67], v126, v97
  v_and_b32 v108, s80, v108
  v_and_b32 v109, s80, v109
  v_and_b32 v110, s80, v110
  v_and_b32 v111, s80, v111
  s_waitcnt vmcnt(1)
  v_perm_b32 v124, v113, v112, s11
  v_perm_b32 v125, v115, v114, s11
  v_perm_b32 v126, v125, v124, s60
  v_perm_b32 v102, v125, v124, s59
  v_and_b32 v126, 0x0f0f0f0f, v126
  v_cmp_ne_u32_e64 s[68:69], v126, v97
  s_waitcnt vmcnt(0)
  v_perm_b32 v124, v117, v116, s11
  v_perm_b32 v125, v119, v118, s11
  v_perm_b32 v126, v125, v124, s60
  v_perm_b32 v103, v125, v124, s59
  v_and_b32 v126, 0x0f0f0f0f, v126
  v_cmp_ne_u32_e64 s[70:71], v126, v97
L_c_test:
  s_or_b64 s[74:75], s[64:65], s[66:67]
  s_or_b64 s[62:63], s[68:69], s[70:71]
  s_or_b64 s[74:75], s[74:75], s[62:63]
  s_cbranch_scc1 L_c_retry
  s_mov_b64 exec, -1
  v_max3_f32 v124, v100, v101, v102
  v_max_f32 v124, v124, v103
  v_and_b32 v112, s80, v112
  v_and_b32 v113, s80, v113
  v_max_f32_dpp v124, v124, v124 row_ror:4 row_mask:0xf bank_mask:0xf
  v_and_b32 v114, s80, v114
  v_and_b32 v115, s80, v115
  v_max_f32_dpp v124, v124, v124 row_ror:8 row_mask:0xf bank_mask:0xf
  v_mov_b32 v125, v124
  v_and_b32 v116, s80, v116
  v_and_b32 v117, s80, v117
  v_permlane16_swap_b32 v124, v125
  v_max_f32 v124, v124, v125
  v_mov_b32 v125, v124
  v_and_b32 v118, s80, v118
  v_and_b32 v119, s80, v119
  v_permlane32_swap_b32 v124, v125
  v_max_f32 v124, v124, v125
  v_sub_f32 v100, v100, v124
  v_sub_f32 v101, v101, v124
  v_sub_f32 v102, v102, v124
  v_sub_f32 v103, v103, v124
  v_exp_f32 v100, v100
  v_exp_f32 v101, v101
  v_exp_f32 v102, v102
  v_exp_f32 v103, v103
  v_mul_f32 v120, v100, v104
  v_mul_f32 v121, v100, v105
  v_mul_f32 v122, v100, v106
  v_mul_f32 v123, v100, v107
  v_add_f32 v125, v100, v101
  v_add_f32 v126, v102, v103
  v_add_f32 v125, v125, v126
  v_fmac_f32 v120, v101, v108
  v_fmac_f32 v121, v101, v109
  v_fmac_f32 v122, v101, v110
  v_fmac_f32 v123, v101, v111
  v_add_f32_dpp v125, v125, v125 row_ror:4 row_mask:0xf bank_mask:0xf
  v_fmac_f32 v120, v102, v112
  v_fmac_f32 v121, v102, v113
  v_fmac_f32 v122, v102, v114
  v_fmac_f32 v123, v102, v115
  v_add_f32_dpp v125, v125, v125 row_ror:8 row_mask:0xf bank_mask:0xf
  v_fmac_f32 v120, v103, v116
  v_fmac_f32 v121, v103, v117
  v_fmac_f32 v122, v103, v118
  v_fmac_f32 v123, v103, v119
  v_mov_b32 v126, v125
  v_permlane16_swap_b32 v120, v121
  v_permlane16_swap_b32 v122, v123
  v_permlane16_swap_b32 v125, v126
  v_add_f32 v120, v120, v121
  v_add_f32 v122, v122, v123
  v_add_f32 v125, v125, v126
  v_mov_b32 v126, v125
  v_permlane32_swap_b32 v120, v122
  s_nop 0
  v_permlane32_swap_b32 v125, v126
  v_add_f32 v120, v120, v122
  v_add_f32 v125, v125, v126
  v_rcp_f32 v125, v125
  v_add_f32_dpp v120, v120, v120 row_ror:4 row_mask:0xf bank_mask:0xf
  s_mov_b32 s62, 0x000f000f
  s_mov_b32 s63, 0x000f000f
  v_add_f32_dpp v120, v120, v120 row_ror:8 row_mask:0xf bank_mask:0xf
  v_mul_f32 v120, v120, v125
  v_cvt_pk_bf16_f32 v120, v120, v120
  s_mov_b64 exec, s[62:63]
  buffer_store_short v120, v98, s[40:43], 0 offen
  s_endpgm
L_c_retry:
  s_sub_u32 s72, s72, 1
  s_cbranch_scc1 L_c_end
  s_wqm_b64 s[64:65], s[64:65]
  s_mov_b64 exec, s[64:65]
  s_cbranch_execz L_c_s1
  buffer_load_dwordx4 v[104:107], v96, s[32:35], 0 offen sc1
L_c_s1:
  s_wqm_b64 s[66:67], s[66:67]
  s_mov_b64 exec, s[66:67]
  s_cbranch_execz L_c_s2
  buffer_load_dwordx4 v[108:111], v96, s[32:35], s8 offen sc1
L_c_s2:
  s_wqm_b64 s[68:69], s[68:69]
  s_mov_b64 exec, s[68:69]
  s_cbranch_execz L_c_s3
  buffer_load_dwordx4 v[112:115], v96, s[32:35], s9 offen sc1
L_c_s3:
  s_wqm_b64 s[70:71], s[70:71]
  s_mov_b64 exec, s[70:71]
  s_cbranch_execz L_c_s4
  buffer_load_dwordx4 v[116:119], v96, s[32:35], s10 offen sc1
L_c_s4:
  s_waitcnt vmcnt(0)
  s_mov_b64 exec, s[64:65]
  v_perm_b32 v124, v105, v104, s11
  v_perm_b32 v125, v107, v106, s11
  v_perm_b32 v126, v125, v124, s60
  v_perm_b32 v100, v125, v124, s59
  v_and_b32 v126, 0x0f0f0f0f, v126
  v_cmp_ne_u32_e64 s[64:65], v126, v97
  v_and_b32 v104, s80, v104
  v_and_b32 v105, s80, v105
  v_and_b32 v106, s80, v106
  v_and_b32 v107, s80, v107
  s_mov_b64 exec, s[66:67]
  v_perm_b32 v124, v109, v108, s11
  v_perm_b32 v125, v111, v110, s11
  v_perm_b32 v126, v125, v124, s60
  v_perm_b32 v101, v125, v124, s59
  v_and_b32 v126, 0x0f0f0f0f, v126
  v_cmp_ne_u32_e64 s[66:67], v126, v97
  v_and_b32 v108, s80, v108
  v_and_b32 v109, s80, v109
  v_and_b32 v110, s80, v110
  v_and_b32 v111, s80, v111
  s_mov_b64 exec, s[68:69]
  v_perm_b32 v124, v113, v112, s11
  v_perm_b32 v125, v115, v114, s11
  v_perm_b32 v126, v125, v124, s60
  v_perm_b32 v102, v125, v124, s59
  v_and_b32 v126, 0x0f0f0f0f, v126
  v_cmp_ne_u32_e64 s[68:69], v126, v97
  s_mov_b64 exec, s[70:71]
  v_perm_b32 v124, v117, v116, s11
  v_perm_b32 v125, v119, v118, s11
  v_perm_b32 v126, v125, v124, s60
  v_perm_b32 v103, v125, v124, s59
  v_and_b32 v126, 0x0f0f0f0f, v126
  v_cmp_ne_u32_e64 s[70:71], v126, v97
  s_branch L_c_test
L_w2:
  s_mov_b64 exec, 1
  buffer_atomic_add v94, v99, s[32:35], 0 offen sc0 sc1
  s_waitcnt vmcnt(0)
  v_cmp_eq_u32 vcc, 63, v94
  s_cbranch_vccz L_fin
  buffer_store_dword v95, v99, s[32:35], 0 offen offset:2048 sc0 sc1
L_c_end:
L_fin:
L_end:
  s_endpgm
L_mknonce:
  s_memrealtime s[84:85]
  v_mov_b32 v94, 0
  v_mul_u32_u24 v95, 4352, v2
  v_add_u32 v95, 2228224, v95
  s_mov_b64 exec, 15
  global_store_dword v95, v94, s[22:23] sc0 sc1
  s_waitcnt lgkmcnt(0)
  s_mul_i32 s86, s84, 0x9E3779B9
  s_mul_i32 s87, s85, 0x7F4A7C15
  s_add_u32 s86, s86, s87
  s_mul_hi_u32 s87, s84, 0x7F4A7C15
  s_add_u32 s86, s86, s87
  s_mul_i32 s84, s84, 0x7F4A7C15
  s_or_b32 s85, s86, 0x80000000
  v_mov_b32 v92, s84
  v_mov_b32 v93, s85
  s_waitcnt vmcnt(0)
  s_mov_b64 exec, 1
  global_store_dwordx2 v94, v[92:93], s[20:21] offset:192 sc0 sc1
  s_mov_b64 exec, -1
  s_branch L_nonced
L_again:
  s_load_dword s48, s[54:55], 5120
  s_load_dword s49, s[54:55], 6144
  s_load_dword s50, s[54:55], 7168
  s_add_u32 s61, s61, 1280
  s_waitcnt vmcnt(0) lgkmcnt(0)
  s_nop 7
  s_branch L_round
L_rescale:
  v_sub_f32 v15, v12, v13
  v_exp_f32 v15, v15
  s_nop 0
  v_mul_f32 v56, v56, v15
  v_mul_f32 v57, v57, v15
  v_mul_f32 v58, v58, v15
  v_mul_f32 v59, v59, v15
  v_mul_f32 v60, v60, v15
  v_mul_f32 v61, v61, v15
  v_mul_f32 v62, v62, v15
  v_mul_f32 v63, v63, v15
  v_mul_f32 v64, v64, v15
  v_mul_f32 v65, v65, v15
  v_mul_f32 v66, v66, v15
  v_mul_f32 v67, v67, v15
  v_mul_f32 v68, v68, v15
  v_mul_f32 v69, v69, v15
  v_mul_f32 v70, v70, v15
  v_mul_f32 v71, v71, v15
  v_mul_f32 v72, v72, v15
  v_mul_f32 v73, v73, v15
  v_mul_f32 v74, v74, v15
  v_mul_f32 v75, v75, v15
  v_mul_f32 v76, v76, v15
  v_mul_f32 v77, v77, v15
  v_mul_f32 v78, v78, v15
  v_mul_f32 v79, v79, v15
  v_mul_f32 v80, v80, v15
  v_mul_f32 v81, v81, v15
  v_mul_f32 v82, v82, v15
  v_mul_f32 v83, v83, v15
  v_mul_f32 v84, v84, v15
  v_mul_f32 v85, v85, v15
  v_mul_f32 v86, v86, v15
  v_mul_f32 v87, v87, v15
  v_mul_f32 v88, v88, v15
  v_mul_f32 v89, v89, v15
  v_mul_f32 v90, v90, v15
  v_mul_f32 v91, v91, v15
  s_branch L_rescaled
.fill (8192 - (. - standalone__paged_block_table_kv_pagedattention__decode_kernel)) / 4, 4, 0xbf810000
.section .rodata,"a"
.p2align 6
.amdhsa_kernel standalone__paged_block_table_kv_pagedattention__decode_kernel
  .amdhsa_next_free_vgpr 256
  .amdhsa_next_free_sgpr 102
  .amdhsa_accum_offset 256
  .amdhsa_group_segment_fixed_size 0
  .amdhsa_kernarg_size 64
  .amdhsa_user_sgpr_count 2
  .amdhsa_user_sgpr_kernarg_segment_ptr 1
  .amdhsa_system_sgpr_workgroup_id_x 1
.end_amdhsa_kernel
```
